```python
import torch

def _softmax(x, axis=-1):
    return torch.softmax(x, dim=axis)

def _gelu(x):
    return torch.nn.functional.gelu(x, approximate='tanh')

def _silu(x):
    return torch.nn.functional.silu(x)

def _sigmoid(x):
    return torch.sigmoid(x)

def _layernorm(x, axis=-1, eps=1e-05):
    m = x.mean(dim=axis, keepdim=True)
    v = x.var(dim=axis, keepdim=True, unbiased=False)
    return (x - m) / torch.sqrt(v + eps)

def _scatter_add(tgt, idx, src, axis=0):
    return tgt.clone().index_add_(axis, idx, src)

def _segment_sum(src, seg, n):
    out = torch.zeros((n,) + src.shape[1:], dtype=src.dtype)
    return out.index_add_(0, seg, src)

def _pad(x, pw):
    flat = tuple((v for pair in reversed(pw) for v in pair))
    return torch.nn.functional.pad(x, flat)
kernel_name = 'standalone__tree_speculative_verify_tree_attention_over_candidate_token_tree__sampling'

def setup_inputs():

    _w = lambda a: (lambda t: t.to(torch.bfloat16) if t.is_floating_point() else t)(torch.as_tensor(a))
    B, Hq, Hkv, T, C, D = (32, 16, 8, 8, 2048, 256)
    tree_mask = torch.zeros((B, T, T), dtype=float)
    for b in range(B):
        parent = torch.zeros(T, dtype=torch.int64)
        for i in range(1, T):
            parent[i] = int(torch.randint(0, i, (1,)).item())
        for i in range(T):
            j = i
            tree_mask[b, i, j] = 1.0
            while j > 0:
                j = parent[j]
                tree_mask[b, i, j] = 1.0
    return {'q': _w((lambda *s: torch.randn(*s, dtype=torch.bfloat16) * 0.8)(B, Hq, T, D)), 'k_cache': _w((lambda *s: torch.randn(*s, dtype=torch.bfloat16) * 0.8)(B, Hkv, C, D)), 'v_cache': _w((lambda *s: torch.randn(*s, dtype=torch.bfloat16) * 0.05)(B, Hkv, C, D)), 'k_tree': _w((lambda *s: torch.randn(*s, dtype=torch.bfloat16) * 0.8)(B, Hkv, T, D)), 'v_tree': _w((lambda *s: torch.randn(*s, dtype=torch.bfloat16) * 0.05)(B, Hkv, T, D)), 'tree_mask': _w(tree_mask)}

def reference(q, k_cache, v_cache, k_tree, v_tree, tree_mask):
    B, Hq, T, D = q.shape
    Hkv, C = (k_cache.shape[1], k_cache.shape[2])
    rep = Hq // Hkv
    kc = (lambda x, n, axis: torch.repeat_interleave(x, n, dim=axis))(k_cache, rep, axis=1)
    vc = (lambda x, n, axis: torch.repeat_interleave(x, n, dim=axis))(v_cache, rep, axis=1)
    kt = (lambda x, n, axis: torch.repeat_interleave(x, n, dim=axis))(k_tree, rep, axis=1)
    vt = (lambda x, n, axis: torch.repeat_interleave(x, n, dim=axis))(v_tree, rep, axis=1)
    k = torch.concatenate([kc, kt], axis=2)
    v = torch.concatenate([vc, vt], axis=2)
    scale = D ** (-0.5)
    scores = torch.einsum('bhqd,bhkd->bhqk', q, k) * scale
    ctx_mask = torch.ones((B, 1, T, C), dtype=scores.dtype)
    tm = tree_mask[:, None, :, :].clone()
    full_mask = torch.concatenate([ctx_mask, tm], axis=-1)
    scores = scores + (1.0 - full_mask) * -1000000000.0
    p = _softmax(scores, axis=-1)
    return torch.einsum('bhqk,bhkd->bhqd', p, v)
```

```asm
; @launch grid=(256,1,1) block=(128,1,1) lds=82176
.amdgcn_target "amdgcn-amd-amdhsa--gfx950"
.text
.globl standalone__tree_speculative_verify_tree_attention_over_candidate_token_tree__sampling_kernel
.p2align 8
.type standalone__tree_speculative_verify_tree_attention_over_candidate_token_tree__sampling_kernel,@function
standalone__tree_speculative_verify_tree_attention_over_candidate_token_tree__sampling_kernel:
    s_cmp_ge_u32 s2, 256
    s_cbranch_scc1 L_done
    s_load_dwordx16 s[4:19], s[0:1], 0
    s_bfe_u32 s3, s2, 0x10000
    s_bfe_u32 s20, s2, 0x10001
    s_lshl_b32 s20, s20, 4
    s_or_b32 s3, s3, s20
    s_bfe_u32 s20, s2, 0x10002
    s_lshl_b32 s20, s20, 3
    s_or_b32 s3, s3, s20
    s_bfe_u32 s20, s2, 0x20003
    s_lshl_b32 s20, s20, 1
    s_or_b32 s3, s3, s20
    s_bfe_u32 s20, s2, 0x30005
    s_lshl_b32 s20, s20, 5
    s_or_b32 s3, s3, s20
    s_mov_b32 s2, s3
    v_and_b32 v1, 63, v0
    v_lshrrev_b32 v2, 6, v0
    v_lshrrev_b32 v3, 5, v1
    v_readfirstlane_b32 s36, v2
    v_and_b32 v4, 31, v1
    v_lshlrev_b32 v5, 1, v3
    v_xor_b32 v4, v4, v5
    v_lshlrev_b32 v4, 4, v4
    v_lshl_add_u32 v10, v3, 9, v4
    v_xor_b32 v11, 64, v10
    v_xor_b32 v12, 128, v10
    v_xor_b32 v13, 192, v10
    v_and_b32 v2, 15, v1
    v_lshrrev_b32 v3, 4, v1
    v_and_b32 v4, 7, v2
    v_lshlrev_b32 v4, 5, v4
    v_lshlrev_b32 v5, 4, v3
    v_xor_b32 v4, v4, v5
    v_lshl_add_u32 v14, v2, 9, v4
    v_xor_b32 v15, 64, v14
    v_xor_b32 v16, 128, v14
    v_xor_b32 v17, 192, v14
    v_lshrrev_b32 v2, 2, v1
    v_and_b32 v3, 7, v2
    v_lshlrev_b32 v3, 5, v3
    v_and_b32 v4, 3, v1
    v_lshlrev_b32 v4, 3, v4
    v_or_b32 v3, v3, v4
    v_lshl_add_u32 v18, v2, 9, v3
    v_xor_b32 v19, 32, v18
    v_xor_b32 v20, 64, v18
    v_xor_b32 v21, 96, v18
    v_xor_b32 v22, 128, v18
    v_xor_b32 v23, 160, v18
    v_xor_b32 v24, 192, v18
    v_xor_b32 v25, 224, v18
    v_and_b32 v2, 7, v1
    v_lshlrev_b32 v2, 4, v2
    v_bfe_u32 v3, v1, 4, 1
    v_lshl_add_u32 v6, v3, 3, v2
    s_mul_i32 s37, s36, 32768
    s_mul_i32 s38, s36, 8192
    s_mov_b32 s41, 0x3db8aa3b
    s_lshl_b32 s42, s2, 20
    s_lshr_b32 s43, s2, 12
    s_waitcnt lgkmcnt(0)
    s_add_u32 s20, s6, s42
    s_addc_u32 s21, s7, s43
    s_mov_b32 s22, 1048576
    s_mov_b32 s23, 0x20000
    s_add_u32 s24, s8, s42
    s_addc_u32 s25, s9, s43
    s_mov_b32 s26, 1048576
    s_mov_b32 s27, 0x20000
    s_mul_i32 s42, s36, 2
    s_add_u32 s42, s42, 0
    s_lshl_b32 s43, s2, 13
    s_add_u32 s28, s4, s43
    s_addc_u32 s29, s5, 0
    s_lshl_b32 s43, s2, 12
    s_cmp_eq_u32 s42, 2
    s_cselect_b32 s32, s10, s12
    s_cselect_b32 s33, s11, s13
    s_add_u32 s32, s32, s43
    s_addc_u32 s33, s33, 0
    s_cmp_lt_u32 s42, 2
    s_cselect_b32 s28, s28, s32
    s_cselect_b32 s29, s29, s33
    s_mov_b32 s30, 8192
    s_cselect_b32 s30, s30, 4096
    s_mov_b32 s31, 0x20000
    s_cmp_eq_u32 s42, 1
    s_cselect_b32 s39, 4096, 0
    s_lshl_b32 s42, s42, 12
    s_add_u32 m0, s42, 65536
    s_nop 0
    buffer_load_dwordx4 v10, s[28:31], s39 offen nt lds
    buffer_load_dwordx4 v11, s[28:31], s39 offen offset:1024 nt lds
    buffer_load_dwordx4 v12, s[28:31], s39 offen offset:2048 nt lds
    buffer_load_dwordx4 v13, s[28:31], s39 offen offset:3072 nt lds
    s_mul_i32 s42, s36, 2
    s_add_u32 s42, s42, 1
    s_lshl_b32 s43, s2, 13
    s_add_u32 s28, s4, s43
    s_addc_u32 s29, s5, 0
    s_lshl_b32 s43, s2, 12
    s_cmp_eq_u32 s42, 2
    s_cselect_b32 s32, s10, s12
    s_cselect_b32 s33, s11, s13
    s_add_u32 s32, s32, s43
    s_addc_u32 s33, s33, 0
    s_cmp_lt_u32 s42, 2
    s_cselect_b32 s28, s28, s32
    s_cselect_b32 s29, s29, s33
    s_mov_b32 s30, 8192
    s_cselect_b32 s30, s30, 4096
    s_mov_b32 s31, 0x20000
    s_cmp_eq_u32 s42, 1
    s_cselect_b32 s39, 4096, 0
    s_lshl_b32 s42, s42, 12
    s_add_u32 m0, s42, 65536
    s_nop 0
    buffer_load_dwordx4 v10, s[28:31], s39 offen nt lds
    buffer_load_dwordx4 v11, s[28:31], s39 offen offset:1024 nt lds
    buffer_load_dwordx4 v12, s[28:31], s39 offen offset:2048 nt lds
    buffer_load_dwordx4 v13, s[28:31], s39 offen offset:3072 nt lds
    s_lshr_b32 s42, s2, 3
    s_lshl_b32 s42, s42, 7
    s_add_u32 s44, s14, s42
    s_addc_u32 s45, s15, 0
    s_mov_b32 s46, 128
    s_mov_b32 s47, 0x20000
    buffer_load_dwordx2 v[28:29], v6, s[44:47], 0 offen nt
    s_add_u32 s39, s38, 0
    s_add_u32 m0, s37, 0
    s_nop 0
    buffer_load_dwordx4 v10, s[20:23], s39 offen nt lds
    buffer_load_dwordx4 v11, s[20:23], s39 offen offset:1024 nt lds
    buffer_load_dwordx4 v12, s[20:23], s39 offen offset:2048 nt lds
    buffer_load_dwordx4 v13, s[20:23], s39 offen offset:3072 nt lds
    s_add_u32 s39, s38, 4096
    s_add_u32 m0, s37, 4096
    s_nop 0
    buffer_load_dwordx4 v10, s[20:23], s39 offen nt lds
    buffer_load_dwordx4 v11, s[20:23], s39 offen offset:1024 nt lds
    buffer_load_dwordx4 v12, s[20:23], s39 offen offset:2048 nt lds
    buffer_load_dwordx4 v13, s[20:23], s39 offen offset:3072 nt lds
    s_add_u32 s39, s38, 0
    s_add_u32 m0, s37, 8192
    s_nop 0
    buffer_load_dwordx4 v10, s[24:27], s39 offen nt lds
    buffer_load_dwordx4 v11, s[24:27], s39 offen offset:1024 nt lds
    buffer_load_dwordx4 v12, s[24:27], s39 offen offset:2048 nt lds
    buffer_load_dwordx4 v13, s[24:27], s39 offen offset:3072 nt lds
    s_add_u32 s39, s38, 4096
    s_add_u32 m0, s37, 12288
    s_nop 0
    buffer_load_dwordx4 v10, s[24:27], s39 offen nt lds
    buffer_load_dwordx4 v11, s[24:27], s39 offen offset:1024 nt lds
    buffer_load_dwordx4 v12, s[24:27], s39 offen offset:2048 nt lds
    buffer_load_dwordx4 v13, s[24:27], s39 offen offset:3072 nt lds
    s_lshl_b32 s43, s2, 13
    s_add_u32 s32, s16, s43
    s_addc_u32 s33, s17, 0
    s_mov_b32 s34, 8192
    s_mov_b32 s35, 0x20000
    v_mov_b32 v148, 0
    v_mov_b32 v149, 0
    v_mov_b32 v150, 0
    v_mov_b32 v151, 0
    v_mov_b32 v152, 0
    v_mov_b32 v153, 0
    v_mov_b32 v154, 0
    v_mov_b32 v155, 0
    v_mov_b32 v156, 0
    v_mov_b32 v157, 0
    v_mov_b32 v158, 0
    v_mov_b32 v159, 0
    v_mov_b32 v160, 0
    v_mov_b32 v161, 0
    v_mov_b32 v162, 0
    v_mov_b32 v163, 0
    v_mov_b32 v164, 0
    v_mov_b32 v165, 0
    v_mov_b32 v166, 0
    v_mov_b32 v167, 0
    v_mov_b32 v168, 0
    v_mov_b32 v169, 0
    v_mov_b32 v170, 0
    v_mov_b32 v171, 0
    v_mov_b32 v172, 0
    v_mov_b32 v173, 0
    v_mov_b32 v174, 0
    v_mov_b32 v175, 0
    v_mov_b32 v176, 0
    v_mov_b32 v177, 0
    v_mov_b32 v178, 0
    v_mov_b32 v179, 0
    v_mov_b32 v180, 0
    v_mov_b32 v181, 0
    v_mov_b32 v182, 0
    v_mov_b32 v183, 0
    v_mov_b32 v184, 0
    v_mov_b32 v185, 0
    v_mov_b32 v186, 0
    v_mov_b32 v187, 0
    v_mov_b32 v188, 0
    v_mov_b32 v189, 0
    v_mov_b32 v190, 0
    v_mov_b32 v191, 0
    v_mov_b32 v192, 0
    v_mov_b32 v193, 0
    v_mov_b32 v194, 0
    v_mov_b32 v195, 0
    v_mov_b32 v196, 0
    v_mov_b32 v197, 0
    v_mov_b32 v198, 0
    v_mov_b32 v199, 0
    v_mov_b32 v200, 0
    v_mov_b32 v201, 0
    v_mov_b32 v202, 0
    v_mov_b32 v203, 0
    v_mov_b32 v204, 0
    v_mov_b32 v205, 0
    v_mov_b32 v206, 0
    v_mov_b32 v207, 0
    v_mov_b32 v208, 0
    v_mov_b32 v209, 0
    v_mov_b32 v210, 0
    v_mov_b32 v211, 0
    v_mov_b32 v26, 0xff800000
    v_mov_b32 v27, 0
    s_waitcnt vmcnt(16)
    s_barrier
    v_add_u32 v212, 65536, v14
    v_add_u32 v213, 65536, v15
    v_add_u32 v214, 65536, v16
    v_add_u32 v215, 65536, v17
    ds_read_b128 v[52:55], v212 offset:0
    ds_read_b128 v[56:59], v213 offset:0
    ds_read_b128 v[60:63], v214 offset:0
    ds_read_b128 v[64:67], v215 offset:0
    ds_read_b128 v[68:71], v212 offset:256
    ds_read_b128 v[72:75], v213 offset:256
    ds_read_b128 v[76:79], v214 offset:256
    ds_read_b128 v[80:83], v215 offset:256
    s_cmp_lg_u32 s36, 0
    s_cbranch_scc1 L_notree
    v_add_u32 v212, 73728, v14
    v_add_u32 v213, 73728, v15
    v_add_u32 v214, 73728, v16
    v_add_u32 v215, 73728, v17
    ds_read_b128 v[84:87], v212 offset:0
    ds_read_b128 v[88:91], v213 offset:0
    ds_read_b128 v[92:95], v214 offset:0
    ds_read_b128 v[96:99], v215 offset:0
    ds_read_b128 v[100:103], v212 offset:256
    ds_read_b128 v[104:107], v213 offset:256
    ds_read_b128 v[108:111], v214 offset:256
    ds_read_b128 v[112:115], v215 offset:256
    s_waitcnt lgkmcnt(0)
    v_mfma_f32_16x16x32_bf16 v[32:35], v[84:87], v[52:55], 0
    v_mfma_f32_16x16x32_bf16 v[32:35], v[88:91], v[56:59], v[32:35]
    v_mfma_f32_16x16x32_bf16 v[32:35], v[92:95], v[60:63], v[32:35]
    v_mfma_f32_16x16x32_bf16 v[32:35], v[96:99], v[64:67], v[32:35]
    v_mfma_f32_16x16x32_bf16 v[32:35], v[100:103], v[68:71], v[32:35]
    v_mfma_f32_16x16x32_bf16 v[32:35], v[104:107], v[72:75], v[32:35]
    v_mfma_f32_16x16x32_bf16 v[32:35], v[108:111], v[76:79], v[32:35]
    v_mfma_f32_16x16x32_bf16 v[32:35], v[112:115], v[80:83], v[32:35]
    v_and_b32 v212, 0xfff, v18
    v_and_b32 v213, 0xfff, v19
    v_and_b32 v214, 0xfff, v20
    v_and_b32 v215, 0xfff, v21
    v_and_b32 v216, 0xfff, v22
    v_and_b32 v217, 0xfff, v23
    v_and_b32 v218, 0xfff, v24
    v_and_b32 v219, 0xfff, v25
    v_add_u32 v212, 77824, v212
    v_add_u32 v213, 77824, v213
    v_add_u32 v214, 77824, v214
    v_add_u32 v215, 77824, v215
    v_add_u32 v216, 77824, v216
    v_add_u32 v217, 77824, v217
    v_add_u32 v218, 77824, v218
    v_add_u32 v219, 77824, v219
    v_lshlrev_b32 v44, 16, v28
    v_and_b32 v45, 0xffff0000, v28
    v_lshlrev_b32 v46, 16, v29
    v_and_b32 v47, 0xffff0000, v29
    s_mov_b32 s42, 0xd06e6b28
    v_sub_f32 v44, 1.0, v44
    v_sub_f32 v45, 1.0, v45
    v_sub_f32 v46, 1.0, v46
    v_sub_f32 v47, 1.0, v47
    ds_read_b64_tr_b16 v[84:85], v212 offset:0
    ds_read_b64_tr_b16 v[88:89], v213 offset:0
    ds_read_b64_tr_b16 v[92:93], v214 offset:0
    ds_read_b64_tr_b16 v[96:97], v215 offset:0
    ds_read_b64_tr_b16 v[100:101], v216 offset:0
    ds_read_b64_tr_b16 v[104:105], v217 offset:0
    ds_read_b64_tr_b16 v[108:109], v218 offset:0
    ds_read_b64_tr_b16 v[112:113], v219 offset:0
    ds_read_b64_tr_b16 v[116:117], v212 offset:256
    ds_read_b64_tr_b16 v[120:121], v213 offset:256
    ds_read_b64_tr_b16 v[124:125], v214 offset:256
    ds_read_b64_tr_b16 v[128:129], v215 offset:256
    ds_read_b64_tr_b16 v[132:133], v216 offset:256
    ds_read_b64_tr_b16 v[136:137], v217 offset:256
    ds_read_b64_tr_b16 v[140:141], v218 offset:256
    ds_read_b64_tr_b16 v[144:145], v219 offset:256
    v_cmp_gt_u32 vcc, 32, v1
    v_mov_b32 v5, 0xff800000
    s_nop 3
    v_fma_f32 v32, v44, s42, v32
    v_fma_f32 v33, v45, s42, v33
    v_fma_f32 v34, v46, s42, v34
    v_fma_f32 v35, v47, s42, v35
    v_cndmask_b32 v32, v5, v32, vcc
    v_cndmask_b32 v33, v5, v33, vcc
    v_cndmask_b32 v34, v5, v34, vcc
    v_cndmask_b32 v35, v5, v35, vcc
    v_max3_f32 v2, v32, v33, v34
    v_max_f32 v2, v2, v35
    v_mov_b32 v3, v2
    s_nop 1
    v_permlane32_swap_b32 v2, v3
    s_nop 0
    v_max_f32 v2, v2, v3
    v_mov_b32 v3, v2
    s_nop 1
    v_permlane16_swap_b32 v2, v3
    s_nop 0
    v_max3_f32 v2, v2, v3, v26
    v_mul_f32 v31, s41, v2
    v_fma_f32 v30, v26, s41, -v31
    v_mov_b32 v26, v2
    v_fma_f32 v44, v32, s41, -v31
    v_fma_f32 v45, v33, s41, -v31
    v_fma_f32 v46, v34, s41, -v31
    v_fma_f32 v47, v35, s41, -v31
    v_exp_f32 v30, v30
    v_exp_f32 v44, v44
    v_exp_f32 v45, v45
    v_exp_f32 v46, v46
    v_exp_f32 v47, v47
    s_nop 0
    v_mul_f32 v27, v27, v30
    v_cvt_pk_bf16_f32 v40, v44, v45
    v_cvt_pk_bf16_f32 v41, v46, v47
    v_add_f32 v2, v44, v45
    v_add_f32 v3, v46, v47
    v_add_f32 v2, v2, v3
    v_add_f32 v27, v27, v2
    v_pk_mul_f32 v[148:149], v[148:149], v[30:31] op_sel_hi:[1,0]
    v_pk_mul_f32 v[150:151], v[150:151], v[30:31] op_sel_hi:[1,0]
    v_pk_mul_f32 v[152:153], v[152:153], v[30:31] op_sel_hi:[1,0]
    v_pk_mul_f32 v[154:155], v[154:155], v[30:31] op_sel_hi:[1,0]
    v_pk_mul_f32 v[156:157], v[156:157], v[30:31] op_sel_hi:[1,0]
    v_pk_mul_f32 v[158:159], v[158:159], v[30:31] op_sel_hi:[1,0]
    v_pk_mul_f32 v[160:161], v[160:161], v[30:31] op_sel_hi:[1,0]
    v_pk_mul_f32 v[162:163], v[162:163], v[30:31] op_sel_hi:[1,0]
    v_pk_mul_f32 v[164:165], v[164:165], v[30:31] op_sel_hi:[1,0]
    v_pk_mul_f32 v[166:167], v[166:167], v[30:31] op_sel_hi:[1,0]
    v_pk_mul_f32 v[168:169], v[168:169], v[30:31] op_sel_hi:[1,0]
    v_pk_mul_f32 v[170:171], v[170:171], v[30:31] op_sel_hi:[1,0]
    v_pk_mul_f32 v[172:173], v[172:173], v[30:31] op_sel_hi:[1,0]
    v_pk_mul_f32 v[174:175], v[174:175], v[30:31] op_sel_hi:[1,0]
    v_pk_mul_f32 v[176:177], v[176:177], v[30:31] op_sel_hi:[1,0]
    v_pk_mul_f32 v[178:179], v[178:179], v[30:31] op_sel_hi:[1,0]
    v_pk_mul_f32 v[180:181], v[180:181], v[30:31] op_sel_hi:[1,0]
    v_pk_mul_f32 v[182:183], v[182:183], v[30:31] op_sel_hi:[1,0]
    v_pk_mul_f32 v[184:185], v[184:185], v[30:31] op_sel_hi:[1,0]
    v_pk_mul_f32 v[186:187], v[186:187], v[30:31] op_sel_hi:[1,0]
    v_pk_mul_f32 v[188:189], v[188:189], v[30:31] op_sel_hi:[1,0]
    v_pk_mul_f32 v[190:191], v[190:191], v[30:31] op_sel_hi:[1,0]
    v_pk_mul_f32 v[192:193], v[192:193], v[30:31] op_sel_hi:[1,0]
    v_pk_mul_f32 v[194:195], v[194:195], v[30:31] op_sel_hi:[1,0]
    v_pk_mul_f32 v[196:197], v[196:197], v[30:31] op_sel_hi:[1,0]
    v_pk_mul_f32 v[198:199], v[198:199], v[30:31] op_sel_hi:[1,0]
    v_pk_mul_f32 v[200:201], v[200:201], v[30:31] op_sel_hi:[1,0]
    v_pk_mul_f32 v[202:203], v[202:203], v[30:31] op_sel_hi:[1,0]
    v_pk_mul_f32 v[204:205], v[204:205], v[30:31] op_sel_hi:[1,0]
    v_pk_mul_f32 v[206:207], v[206:207], v[30:31] op_sel_hi:[1,0]
    v_pk_mul_f32 v[208:209], v[208:209], v[30:31] op_sel_hi:[1,0]
    v_pk_mul_f32 v[210:211], v[210:211], v[30:31] op_sel_hi:[1,0]
    s_waitcnt lgkmcnt(0)
    v_mfma_f32_16x16x16_bf16 v[148:151], v[84:85], v[40:41], v[148:151]
    v_mfma_f32_16x16x16_bf16 v[152:155], v[88:89], v[40:41], v[152:155]
    v_mfma_f32_16x16x16_bf16 v[156:159], v[92:93], v[40:41], v[156:159]
    v_mfma_f32_16x16x16_bf16 v[160:163], v[96:97], v[40:41], v[160:163]
    v_mfma_f32_16x16x16_bf16 v[164:167], v[100:101], v[40:41], v[164:167]
    v_mfma_f32_16x16x16_bf16 v[168:171], v[104:105], v[40:41], v[168:171]
    v_mfma_f32_16x16x16_bf16 v[172:175], v[108:109], v[40:41], v[172:175]
    v_mfma_f32_16x16x16_bf16 v[176:179], v[112:113], v[40:41], v[176:179]
    v_mfma_f32_16x16x16_bf16 v[180:183], v[116:117], v[40:41], v[180:183]
    v_mfma_f32_16x16x16_bf16 v[184:187], v[120:121], v[40:41], v[184:187]
    v_mfma_f32_16x16x16_bf16 v[188:191], v[124:125], v[40:41], v[188:191]
    v_mfma_f32_16x16x16_bf16 v[192:195], v[128:129], v[40:41], v[192:195]
    v_mfma_f32_16x16x16_bf16 v[196:199], v[132:133], v[40:41], v[196:199]
    v_mfma_f32_16x16x16_bf16 v[200:203], v[136:137], v[40:41], v[200:203]
    v_mfma_f32_16x16x16_bf16 v[204:207], v[140:141], v[40:41], v[204:207]
    v_mfma_f32_16x16x16_bf16 v[208:211], v[144:145], v[40:41], v[208:211]
L_notree:
    v_and_b32 v2, 15, v1
    v_lshlrev_b32 v3, 3, v2
    v_add_u32 v222, 81920, v3
    s_lshl_b32 s42, s36, 7
    v_add_u32 v221, s42, v222
    v_lshrrev_b32 v3, 4, v1
    v_lshrrev_b32 v4, 1, v3
    v_and_b32 v5, 7, v2
    v_xor_b32 v4, v4, v5
    v_and_b32 v3, 1, v3
    v_lshl_add_u32 v4, v3, 4, v4
    v_lshlrev_b32 v4, 4, v4
    v_lshl_add_u32 v4, v2, 10, v4
    v_add_u32 v212, s37, v4
    v_xor_b32 v213, 32, v212
    v_xor_b32 v214, 64, v212
    v_xor_b32 v215, 96, v212
    v_lshrrev_b32 v2, 3, v1
    s_mul_i32 s42, s36, 8
    v_add_u32 v2, s42, v2
    v_and_b32 v3, 7, v1
    v_and_b32 v5, 7, v2
    v_xor_b32 v5, v5, v3
    v_lshlrev_b32 v5, 4, v5
    v_lshl_add_u32 v216, v2, 10, v5
    v_lshlrev_b32 v220, 4, v3
    v_lshl_add_u32 v220, v2, 9, v220
    v_add_u32 v14, s37, v14
    v_add_u32 v15, s37, v15
    v_add_u32 v16, s37, v16
    v_add_u32 v17, s37, v17
    v_add_u32 v18, s37, v18
    v_add_u32 v19, s37, v19
    v_add_u32 v20, s37, v20
    v_add_u32 v21, s37, v21
    v_add_u32 v22, s37, v22
    v_add_u32 v23, s37, v23
    v_add_u32 v24, s37, v24
    v_add_u32 v25, s37, v25
    s_waitcnt lgkmcnt(0)
    s_mov_b32 s40, 29
L_loop:
    s_waitcnt vmcnt(8)
    ds_read_b128 v[84:87], v14 offset:0
    ds_read_b128 v[88:91], v15 offset:0
    ds_read_b128 v[92:95], v16 offset:0
    ds_read_b128 v[96:99], v17 offset:0
    ds_read_b128 v[100:103], v14 offset:256
    ds_read_b128 v[104:107], v15 offset:256
    ds_read_b128 v[108:111], v16 offset:256
    ds_read_b128 v[112:115], v17 offset:256
    s_waitcnt lgkmcnt(0)
    v_mfma_f32_16x16x32_bf16 v[32:35], v[84:87], v[52:55], 0
    v_mfma_f32_16x16x32_bf16 v[32:35], v[88:91], v[56:59], v[32:35]
    v_mfma_f32_16x16x32_bf16 v[32:35], v[92:95], v[60:63], v[32:35]
    v_mfma_f32_16x16x32_bf16 v[32:35], v[96:99], v[64:67], v[32:35]
    v_mfma_f32_16x16x32_bf16 v[32:35], v[100:103], v[68:71], v[32:35]
    v_mfma_f32_16x16x32_bf16 v[32:35], v[104:107], v[72:75], v[32:35]
    v_mfma_f32_16x16x32_bf16 v[32:35], v[108:111], v[76:79], v[32:35]
    v_mfma_f32_16x16x32_bf16 v[32:35], v[112:115], v[80:83], v[32:35]
    s_nop 7
    v_max3_f32 v2, v32, v33, v34
    v_max_f32 v2, v2, v35
    v_mov_b32 v3, v2
    s_nop 1
    v_permlane32_swap_b32 v2, v3
    s_nop 0
    v_max_f32 v2, v2, v3
    v_mov_b32 v3, v2
    s_nop 1
    v_permlane16_swap_b32 v2, v3
    s_nop 0
    v_max3_f32 v2, v2, v3, v26
    v_mul_f32 v31, s41, v2
    v_fma_f32 v30, v26, s41, -v31
    v_mov_b32 v26, v2
    v_fma_f32 v44, v32, s41, -v31
    v_fma_f32 v45, v33, s41, -v31
    v_fma_f32 v46, v34, s41, -v31
    v_fma_f32 v47, v35, s41, -v31
    v_exp_f32 v30, v30
    v_exp_f32 v44, v44
    v_exp_f32 v45, v45
    v_exp_f32 v46, v46
    v_exp_f32 v47, v47
    s_nop 0
    v_mul_f32 v27, v27, v30
    v_cvt_pk_bf16_f32 v40, v44, v45
    v_cvt_pk_bf16_f32 v41, v46, v47
    v_add_f32 v2, v44, v45
    v_add_f32 v3, v46, v47
    v_add_f32 v2, v2, v3
    v_add_f32 v27, v27, v2
    v_pk_mul_f32 v[148:149], v[148:149], v[30:31] op_sel_hi:[1,0]
    v_pk_mul_f32 v[150:151], v[150:151], v[30:31] op_sel_hi:[1,0]
    v_pk_mul_f32 v[152:153], v[152:153], v[30:31] op_sel_hi:[1,0]
    v_pk_mul_f32 v[154:155], v[154:155], v[30:31] op_sel_hi:[1,0]
    v_pk_mul_f32 v[156:157], v[156:157], v[30:31] op_sel_hi:[1,0]
    v_pk_mul_f32 v[158:159], v[158:159], v[30:31] op_sel_hi:[1,0]
    v_pk_mul_f32 v[160:161], v[160:161], v[30:31] op_sel_hi:[1,0]
    v_pk_mul_f32 v[162:163], v[162:163], v[30:31] op_sel_hi:[1,0]
    v_pk_mul_f32 v[164:165], v[164:165], v[30:31] op_sel_hi:[1,0]
    v_pk_mul_f32 v[166:167], v[166:167], v[30:31] op_sel_hi:[1,0]
    v_pk_mul_f32 v[168:169], v[168:169], v[30:31] op_sel_hi:[1,0]
    v_pk_mul_f32 v[170:171], v[170:171], v[30:31] op_sel_hi:[1,0]
    v_pk_mul_f32 v[172:173], v[172:173], v[30:31] op_sel_hi:[1,0]
    v_pk_mul_f32 v[174:175], v[174:175], v[30:31] op_sel_hi:[1,0]
    v_pk_mul_f32 v[176:177], v[176:177], v[30:31] op_sel_hi:[1,0]
    v_pk_mul_f32 v[178:179], v[178:179], v[30:31] op_sel_hi:[1,0]
    v_pk_mul_f32 v[180:181], v[180:181], v[30:31] op_sel_hi:[1,0]
    v_pk_mul_f32 v[182:183], v[182:183], v[30:31] op_sel_hi:[1,0]
    v_pk_mul_f32 v[184:185], v[184:185], v[30:31] op_sel_hi:[1,0]
    v_pk_mul_f32 v[186:187], v[186:187], v[30:31] op_sel_hi:[1,0]
    v_pk_mul_f32 v[188:189], v[188:189], v[30:31] op_sel_hi:[1,0]
    v_pk_mul_f32 v[190:191], v[190:191], v[30:31] op_sel_hi:[1,0]
    v_pk_mul_f32 v[192:193], v[192:193], v[30:31] op_sel_hi:[1,0]
    v_pk_mul_f32 v[194:195], v[194:195], v[30:31] op_sel_hi:[1,0]
    v_pk_mul_f32 v[196:197], v[196:197], v[30:31] op_sel_hi:[1,0]
    v_pk_mul_f32 v[198:199], v[198:199], v[30:31] op_sel_hi:[1,0]
    v_pk_mul_f32 v[200:201], v[200:201], v[30:31] op_sel_hi:[1,0]
    v_pk_mul_f32 v[202:203], v[202:203], v[30:31] op_sel_hi:[1,0]
    v_pk_mul_f32 v[204:205], v[204:205], v[30:31] op_sel_hi:[1,0]
    v_pk_mul_f32 v[206:207], v[206:207], v[30:31] op_sel_hi:[1,0]
    v_pk_mul_f32 v[208:209], v[208:209], v[30:31] op_sel_hi:[1,0]
    v_pk_mul_f32 v[210:211], v[210:211], v[30:31] op_sel_hi:[1,0]
    s_waitcnt vmcnt(0)
    ds_read_b64_tr_b16 v[84:85], v18 offset:8192
    ds_read_b64_tr_b16 v[88:89], v19 offset:8192
    ds_read_b64_tr_b16 v[92:93], v20 offset:8192
    ds_read_b64_tr_b16 v[96:97], v21 offset:8192
    ds_read_b64_tr_b16 v[100:101], v22 offset:8192
    ds_read_b64_tr_b16 v[104:105], v23 offset:8192
    ds_read_b64_tr_b16 v[108:109], v24 offset:8192
    ds_read_b64_tr_b16 v[112:113], v25 offset:8192
    ds_read_b64_tr_b16 v[116:117], v18 offset:8448
    ds_read_b64_tr_b16 v[120:121], v19 offset:8448
    ds_read_b64_tr_b16 v[124:125], v20 offset:8448
    ds_read_b64_tr_b16 v[128:129], v21 offset:8448
    ds_read_b64_tr_b16 v[132:133], v22 offset:8448
    ds_read_b64_tr_b16 v[136:137], v23 offset:8448
    ds_read_b64_tr_b16 v[140:141], v24 offset:8448
    ds_read_b64_tr_b16 v[144:145], v25 offset:8448
    s_waitcnt lgkmcnt(0)
    s_add_u32 s39, s38, 16384
    s_add_u32 m0, s37, 16384
    s_nop 0
    buffer_load_dwordx4 v10, s[20:23], s39 offen nt lds
    buffer_load_dwordx4 v11, s[20:23], s39 offen offset:1024 nt lds
    buffer_load_dwordx4 v12, s[20:23], s39 offen offset:2048 nt lds
    buffer_load_dwordx4 v13, s[20:23], s39 offen offset:3072 nt lds
    s_add_u32 s39, s38, 20480
    s_add_u32 m0, s37, 20480
    s_nop 0
    buffer_load_dwordx4 v10, s[20:23], s39 offen nt lds
    buffer_load_dwordx4 v11, s[20:23], s39 offen offset:1024 nt lds
    buffer_load_dwordx4 v12, s[20:23], s39 offen offset:2048 nt lds
    buffer_load_dwordx4 v13, s[20:23], s39 offen offset:3072 nt lds
    s_add_u32 s39, s38, 16384
    s_add_u32 m0, s37, 24576
    s_nop 0
    buffer_load_dwordx4 v10, s[24:27], s39 offen nt lds
    buffer_load_dwordx4 v11, s[24:27], s39 offen offset:1024 nt lds
    buffer_load_dwordx4 v12, s[24:27], s39 offen offset:2048 nt lds
    buffer_load_dwordx4 v13, s[24:27], s39 offen offset:3072 nt lds
    s_add_u32 s39, s38, 20480
    s_add_u32 m0, s37, 28672
    s_nop 0
    buffer_load_dwordx4 v10, s[24:27], s39 offen nt lds
    buffer_load_dwordx4 v11, s[24:27], s39 offen offset:1024 nt lds
    buffer_load_dwordx4 v12, s[24:27], s39 offen offset:2048 nt lds
    buffer_load_dwordx4 v13, s[24:27], s39 offen offset:3072 nt lds
    v_mfma_f32_16x16x16_bf16 v[148:151], v[84:85], v[40:41], v[148:151]
    v_mfma_f32_16x16x16_bf16 v[152:155], v[88:89], v[40:41], v[152:155]
    v_mfma_f32_16x16x16_bf16 v[156:159], v[92:93], v[40:41], v[156:159]
    v_mfma_f32_16x16x16_bf16 v[160:163], v[96:97], v[40:41], v[160:163]
    v_mfma_f32_16x16x16_bf16 v[164:167], v[100:101], v[40:41], v[164:167]
    v_mfma_f32_16x16x16_bf16 v[168:171], v[104:105], v[40:41], v[168:171]
    v_mfma_f32_16x16x16_bf16 v[172:175], v[108:109], v[40:41], v[172:175]
    v_mfma_f32_16x16x16_bf16 v[176:179], v[112:113], v[40:41], v[176:179]
    v_mfma_f32_16x16x16_bf16 v[180:183], v[116:117], v[40:41], v[180:183]
    v_mfma_f32_16x16x16_bf16 v[184:187], v[120:121], v[40:41], v[184:187]
    v_mfma_f32_16x16x16_bf16 v[188:191], v[124:125], v[40:41], v[188:191]
    v_mfma_f32_16x16x16_bf16 v[192:195], v[128:129], v[40:41], v[192:195]
    v_mfma_f32_16x16x16_bf16 v[196:199], v[132:133], v[40:41], v[196:199]
    v_mfma_f32_16x16x16_bf16 v[200:203], v[136:137], v[40:41], v[200:203]
    v_mfma_f32_16x16x16_bf16 v[204:207], v[140:141], v[40:41], v[204:207]
    v_mfma_f32_16x16x16_bf16 v[208:211], v[144:145], v[40:41], v[208:211]
    s_waitcnt vmcnt(8)
    ds_read_b128 v[84:87], v14 offset:16384
    ds_read_b128 v[88:91], v15 offset:16384
    ds_read_b128 v[92:95], v16 offset:16384
    ds_read_b128 v[96:99], v17 offset:16384
    ds_read_b128 v[100:103], v14 offset:16640
    ds_read_b128 v[104:107], v15 offset:16640
    ds_read_b128 v[108:111], v16 offset:16640
    ds_read_b128 v[112:115], v17 offset:16640
    s_waitcnt lgkmcnt(0)
    v_mfma_f32_16x16x32_bf16 v[32:35], v[84:87], v[52:55], 0
    v_mfma_f32_16x16x32_bf16 v[32:35], v[88:91], v[56:59], v[32:35]
    v_mfma_f32_16x16x32_bf16 v[32:35], v[92:95], v[60:63], v[32:35]
    v_mfma_f32_16x16x32_bf16 v[32:35], v[96:99], v[64:67], v[32:35]
    v_mfma_f32_16x16x32_bf16 v[32:35], v[100:103], v[68:71], v[32:35]
    v_mfma_f32_16x16x32_bf16 v[32:35], v[104:107], v[72:75], v[32:35]
    v_mfma_f32_16x16x32_bf16 v[32:35], v[108:111], v[76:79], v[32:35]
    v_mfma_f32_16x16x32_bf16 v[32:35], v[112:115], v[80:83], v[32:35]
    s_nop 7
    v_max3_f32 v2, v32, v33, v34
    v_max_f32 v2, v2, v35
    v_mov_b32 v3, v2
    s_nop 1
    v_permlane32_swap_b32 v2, v3
    s_nop 0
    v_max_f32 v2, v2, v3
    v_mov_b32 v3, v2
    s_nop 1
    v_permlane16_swap_b32 v2, v3
    s_nop 0
    v_max3_f32 v2, v2, v3, v26
    v_mul_f32 v31, s41, v2
    v_fma_f32 v30, v26, s41, -v31
    v_mov_b32 v26, v2
    v_fma_f32 v44, v32, s41, -v31
    v_fma_f32 v45, v33, s41, -v31
    v_fma_f32 v46, v34, s41, -v31
    v_fma_f32 v47, v35, s41, -v31
    v_exp_f32 v30, v30
    v_exp_f32 v44, v44
    v_exp_f32 v45, v45
    v_exp_f32 v46, v46
    v_exp_f32 v47, v47
    s_nop 0
    v_mul_f32 v27, v27, v30
    v_cvt_pk_bf16_f32 v40, v44, v45
    v_cvt_pk_bf16_f32 v41, v46, v47
    v_add_f32 v2, v44, v45
    v_add_f32 v3, v46, v47
    v_add_f32 v2, v2, v3
    v_add_f32 v27, v27, v2
    v_pk_mul_f32 v[148:149], v[148:149], v[30:31] op_sel_hi:[1,0]
    v_pk_mul_f32 v[150:151], v[150:151], v[30:31] op_sel_hi:[1,0]
    v_pk_mul_f32 v[152:153], v[152:153], v[30:31] op_sel_hi:[1,0]
    v_pk_mul_f32 v[154:155], v[154:155], v[30:31] op_sel_hi:[1,0]
    v_pk_mul_f32 v[156:157], v[156:157], v[30:31] op_sel_hi:[1,0]
    v_pk_mul_f32 v[158:159], v[158:159], v[30:31] op_sel_hi:[1,0]
    v_pk_mul_f32 v[160:161], v[160:161], v[30:31] op_sel_hi:[1,0]
    v_pk_mul_f32 v[162:163], v[162:163], v[30:31] op_sel_hi:[1,0]
    v_pk_mul_f32 v[164:165], v[164:165], v[30:31] op_sel_hi:[1,0]
    v_pk_mul_f32 v[166:167], v[166:167], v[30:31] op_sel_hi:[1,0]
    v_pk_mul_f32 v[168:169], v[168:169], v[30:31] op_sel_hi:[1,0]
    v_pk_mul_f32 v[170:171], v[170:171], v[30:31] op_sel_hi:[1,0]
    v_pk_mul_f32 v[172:173], v[172:173], v[30:31] op_sel_hi:[1,0]
    v_pk_mul_f32 v[174:175], v[174:175], v[30:31] op_sel_hi:[1,0]
    v_pk_mul_f32 v[176:177], v[176:177], v[30:31] op_sel_hi:[1,0]
    v_pk_mul_f32 v[178:179], v[178:179], v[30:31] op_sel_hi:[1,0]
    v_pk_mul_f32 v[180:181], v[180:181], v[30:31] op_sel_hi:[1,0]
    v_pk_mul_f32 v[182:183], v[182:183], v[30:31] op_sel_hi:[1,0]
    v_pk_mul_f32 v[184:185], v[184:185], v[30:31] op_sel_hi:[1,0]
    v_pk_mul_f32 v[186:187], v[186:187], v[30:31] op_sel_hi:[1,0]
    v_pk_mul_f32 v[188:189], v[188:189], v[30:31] op_sel_hi:[1,0]
    v_pk_mul_f32 v[190:191], v[190:191], v[30:31] op_sel_hi:[1,0]
    v_pk_mul_f32 v[192:193], v[192:193], v[30:31] op_sel_hi:[1,0]
    v_pk_mul_f32 v[194:195], v[194:195], v[30:31] op_sel_hi:[1,0]
    v_pk_mul_f32 v[196:197], v[196:197], v[30:31] op_sel_hi:[1,0]
    v_pk_mul_f32 v[198:199], v[198:199], v[30:31] op_sel_hi:[1,0]
    v_pk_mul_f32 v[200:201], v[200:201], v[30:31] op_sel_hi:[1,0]
    v_pk_mul_f32 v[202:203], v[202:203], v[30:31] op_sel_hi:[1,0]
    v_pk_mul_f32 v[204:205], v[204:205], v[30:31] op_sel_hi:[1,0]
    v_pk_mul_f32 v[206:207], v[206:207], v[30:31] op_sel_hi:[1,0]
    v_pk_mul_f32 v[208:209], v[208:209], v[30:31] op_sel_hi:[1,0]
    v_pk_mul_f32 v[210:211], v[210:211], v[30:31] op_sel_hi:[1,0]
    s_waitcnt vmcnt(0)
    ds_read_b64_tr_b16 v[84:85], v18 offset:24576
    ds_read_b64_tr_b16 v[88:89], v19 offset:24576
    ds_read_b64_tr_b16 v[92:93], v20 offset:24576
    ds_read_b64_tr_b16 v[96:97], v21 offset:24576
    ds_read_b64_tr_b16 v[100:101], v22 offset:24576
    ds_read_b64_tr_b16 v[104:105], v23 offset:24576
    ds_read_b64_tr_b16 v[108:109], v24 offset:24576
    ds_read_b64_tr_b16 v[112:113], v25 offset:24576
    ds_read_b64_tr_b16 v[116:117], v18 offset:24832
    ds_read_b64_tr_b16 v[120:121], v19 offset:24832
    ds_read_b64_tr_b16 v[124:125], v20 offset:24832
    ds_read_b64_tr_b16 v[128:129], v21 offset:24832
    ds_read_b64_tr_b16 v[132:133], v22 offset:24832
    ds_read_b64_tr_b16 v[136:137], v23 offset:24832
    ds_read_b64_tr_b16 v[140:141], v24 offset:24832
    ds_read_b64_tr_b16 v[144:145], v25 offset:24832
    s_waitcnt lgkmcnt(0)
    s_add_u32 s39, s38, 32768
    s_add_u32 m0, s37, 0
    s_nop 0
    buffer_load_dwordx4 v10, s[20:23], s39 offen nt lds
    buffer_load_dwordx4 v11, s[20:23], s39 offen offset:1024 nt lds
    buffer_load_dwordx4 v12, s[20:23], s39 offen offset:2048 nt lds
    buffer_load_dwordx4 v13, s[20:23], s39 offen offset:3072 nt lds
    s_add_u32 s39, s38, 36864
    s_add_u32 m0, s37, 4096
    s_nop 0
    buffer_load_dwordx4 v10, s[20:23], s39 offen nt lds
    buffer_load_dwordx4 v11, s[20:23], s39 offen offset:1024 nt lds
    buffer_load_dwordx4 v12, s[20:23], s39 offen offset:2048 nt lds
    buffer_load_dwordx4 v13, s[20:23], s39 offen offset:3072 nt lds
    s_add_u32 s39, s38, 32768
    s_add_u32 m0, s37, 8192
    s_nop 0
    buffer_load_dwordx4 v10, s[24:27], s39 offen nt lds
    buffer_load_dwordx4 v11, s[24:27], s39 offen offset:1024 nt lds
    buffer_load_dwordx4 v12, s[24:27], s39 offen offset:2048 nt lds
    buffer_load_dwordx4 v13, s[24:27], s39 offen offset:3072 nt lds
    s_add_u32 s39, s38, 36864
    s_add_u32 m0, s37, 12288
    s_nop 0
    buffer_load_dwordx4 v10, s[24:27], s39 offen nt lds
    buffer_load_dwordx4 v11, s[24:27], s39 offen offset:1024 nt lds
    buffer_load_dwordx4 v12, s[24:27], s39 offen offset:2048 nt lds
    buffer_load_dwordx4 v13, s[24:27], s39 offen offset:3072 nt lds
    v_mfma_f32_16x16x16_bf16 v[148:151], v[84:85], v[40:41], v[148:151]
    v_mfma_f32_16x16x16_bf16 v[152:155], v[88:89], v[40:41], v[152:155]
    v_mfma_f32_16x16x16_bf16 v[156:159], v[92:93], v[40:41], v[156:159]
    v_mfma_f32_16x16x16_bf16 v[160:163], v[96:97], v[40:41], v[160:163]
    v_mfma_f32_16x16x16_bf16 v[164:167], v[100:101], v[40:41], v[164:167]
    v_mfma_f32_16x16x16_bf16 v[168:171], v[104:105], v[40:41], v[168:171]
    v_mfma_f32_16x16x16_bf16 v[172:175], v[108:109], v[40:41], v[172:175]
    v_mfma_f32_16x16x16_bf16 v[176:179], v[112:113], v[40:41], v[176:179]
    v_mfma_f32_16x16x16_bf16 v[180:183], v[116:117], v[40:41], v[180:183]
    v_mfma_f32_16x16x16_bf16 v[184:187], v[120:121], v[40:41], v[184:187]
    v_mfma_f32_16x16x16_bf16 v[188:191], v[124:125], v[40:41], v[188:191]
    v_mfma_f32_16x16x16_bf16 v[192:195], v[128:129], v[40:41], v[192:195]
    v_mfma_f32_16x16x16_bf16 v[196:199], v[132:133], v[40:41], v[196:199]
    v_mfma_f32_16x16x16_bf16 v[200:203], v[136:137], v[40:41], v[200:203]
    v_mfma_f32_16x16x16_bf16 v[204:207], v[140:141], v[40:41], v[204:207]
    v_mfma_f32_16x16x16_bf16 v[208:211], v[144:145], v[40:41], v[208:211]
    s_add_u32 s38, s38, 32768
    s_sub_u32 s40, s40, 1
    s_cmp_lg_u32 s40, 0
    s_cbranch_scc1 L_loop
    s_add_u32 s39, s38, 16384
    s_add_u32 m0, s37, 16384
    s_nop 0
    buffer_load_dwordx4 v10, s[20:23], s39 offen nt lds
    buffer_load_dwordx4 v11, s[20:23], s39 offen offset:1024 nt lds
    buffer_load_dwordx4 v12, s[20:23], s39 offen offset:2048 nt lds
    buffer_load_dwordx4 v13, s[20:23], s39 offen offset:3072 nt lds
    s_add_u32 s39, s38, 20480
    s_add_u32 m0, s37, 20480
    s_nop 0
    buffer_load_dwordx4 v10, s[20:23], s39 offen nt lds
    buffer_load_dwordx4 v11, s[20:23], s39 offen offset:1024 nt lds
    buffer_load_dwordx4 v12, s[20:23], s39 offen offset:2048 nt lds
    buffer_load_dwordx4 v13, s[20:23], s39 offen offset:3072 nt lds
    s_add_u32 s39, s38, 16384
    s_add_u32 m0, s37, 24576
    s_nop 0
    buffer_load_dwordx4 v10, s[24:27], s39 offen nt lds
    buffer_load_dwordx4 v11, s[24:27], s39 offen offset:1024 nt lds
    buffer_load_dwordx4 v12, s[24:27], s39 offen offset:2048 nt lds
    buffer_load_dwordx4 v13, s[24:27], s39 offen offset:3072 nt lds
    s_add_u32 s39, s38, 20480
    s_add_u32 m0, s37, 28672
    s_nop 0
    buffer_load_dwordx4 v10, s[24:27], s39 offen nt lds
    buffer_load_dwordx4 v11, s[24:27], s39 offen offset:1024 nt lds
    buffer_load_dwordx4 v12, s[24:27], s39 offen offset:2048 nt lds
    buffer_load_dwordx4 v13, s[24:27], s39 offen offset:3072 nt lds
    s_mov_b32 s40, 2
L_eloop:
    s_waitcnt vmcnt(24)
    ds_read_b128 v[84:87], v14 offset:0
    ds_read_b128 v[88:91], v15 offset:0
    ds_read_b128 v[92:95], v16 offset:0
    ds_read_b128 v[96:99], v17 offset:0
    ds_read_b128 v[100:103], v14 offset:256
    ds_read_b128 v[104:107], v15 offset:256
    ds_read_b128 v[108:111], v16 offset:256
    ds_read_b128 v[112:115], v17 offset:256
    s_waitcnt lgkmcnt(0)
    v_mfma_f32_16x16x32_bf16 v[32:35], v[84:87], v[52:55], 0
    v_mfma_f32_16x16x32_bf16 v[32:35], v[88:91], v[56:59], v[32:35]
    v_mfma_f32_16x16x32_bf16 v[32:35], v[92:95], v[60:63], v[32:35]
    v_mfma_f32_16x16x32_bf16 v[32:35], v[96:99], v[64:67], v[32:35]
    v_mfma_f32_16x16x32_bf16 v[32:35], v[100:103], v[68:71], v[32:35]
    v_mfma_f32_16x16x32_bf16 v[32:35], v[104:107], v[72:75], v[32:35]
    v_mfma_f32_16x16x32_bf16 v[32:35], v[108:111], v[76:79], v[32:35]
    v_mfma_f32_16x16x32_bf16 v[32:35], v[112:115], v[80:83], v[32:35]
    s_nop 7
    v_max3_f32 v2, v32, v33, v34
    v_max_f32 v2, v2, v35
    v_mov_b32 v3, v2
    s_nop 1
    v_permlane32_swap_b32 v2, v3
    s_nop 0
    v_max_f32 v2, v2, v3
    v_mov_b32 v3, v2
    s_nop 1
    v_permlane16_swap_b32 v2, v3
    s_nop 0
    v_max3_f32 v2, v2, v3, v26
    v_mul_f32 v31, s41, v2
    v_fma_f32 v30, v26, s41, -v31
    v_mov_b32 v26, v2
    v_fma_f32 v44, v32, s41, -v31
    v_fma_f32 v45, v33, s41, -v31
    v_fma_f32 v46, v34, s41, -v31
    v_fma_f32 v47, v35, s41, -v31
    v_exp_f32 v30, v30
    v_exp_f32 v44, v44
    v_exp_f32 v45, v45
    v_exp_f32 v46, v46
    v_exp_f32 v47, v47
    s_nop 0
    v_mul_f32 v27, v27, v30
    v_cvt_pk_bf16_f32 v40, v44, v45
    v_cvt_pk_bf16_f32 v41, v46, v47
    v_add_f32 v2, v44, v45
    v_add_f32 v3, v46, v47
    v_add_f32 v2, v2, v3
    v_add_f32 v27, v27, v2
    v_pk_mul_f32 v[148:149], v[148:149], v[30:31] op_sel_hi:[1,0]
    v_pk_mul_f32 v[150:151], v[150:151], v[30:31] op_sel_hi:[1,0]
    v_pk_mul_f32 v[152:153], v[152:153], v[30:31] op_sel_hi:[1,0]
    v_pk_mul_f32 v[154:155], v[154:155], v[30:31] op_sel_hi:[1,0]
    v_pk_mul_f32 v[156:157], v[156:157], v[30:31] op_sel_hi:[1,0]
    v_pk_mul_f32 v[158:159], v[158:159], v[30:31] op_sel_hi:[1,0]
    v_pk_mul_f32 v[160:161], v[160:161], v[30:31] op_sel_hi:[1,0]
    v_pk_mul_f32 v[162:163], v[162:163], v[30:31] op_sel_hi:[1,0]
    v_pk_mul_f32 v[164:165], v[164:165], v[30:31] op_sel_hi:[1,0]
    v_pk_mul_f32 v[166:167], v[166:167], v[30:31] op_sel_hi:[1,0]
    v_pk_mul_f32 v[168:169], v[168:169], v[30:31] op_sel_hi:[1,0]
    v_pk_mul_f32 v[170:171], v[170:171], v[30:31] op_sel_hi:[1,0]
    v_pk_mul_f32 v[172:173], v[172:173], v[30:31] op_sel_hi:[1,0]
    v_pk_mul_f32 v[174:175], v[174:175], v[30:31] op_sel_hi:[1,0]
    v_pk_mul_f32 v[176:177], v[176:177], v[30:31] op_sel_hi:[1,0]
    v_pk_mul_f32 v[178:179], v[178:179], v[30:31] op_sel_hi:[1,0]
    v_pk_mul_f32 v[180:181], v[180:181], v[30:31] op_sel_hi:[1,0]
    v_pk_mul_f32 v[182:183], v[182:183], v[30:31] op_sel_hi:[1,0]
    v_pk_mul_f32 v[184:185], v[184:185], v[30:31] op_sel_hi:[1,0]
    v_pk_mul_f32 v[186:187], v[186:187], v[30:31] op_sel_hi:[1,0]
    v_pk_mul_f32 v[188:189], v[188:189], v[30:31] op_sel_hi:[1,0]
    v_pk_mul_f32 v[190:191], v[190:191], v[30:31] op_sel_hi:[1,0]
    v_pk_mul_f32 v[192:193], v[192:193], v[30:31] op_sel_hi:[1,0]
    v_pk_mul_f32 v[194:195], v[194:195], v[30:31] op_sel_hi:[1,0]
    v_pk_mul_f32 v[196:197], v[196:197], v[30:31] op_sel_hi:[1,0]
    v_pk_mul_f32 v[198:199], v[198:199], v[30:31] op_sel_hi:[1,0]
    v_pk_mul_f32 v[200:201], v[200:201], v[30:31] op_sel_hi:[1,0]
    v_pk_mul_f32 v[202:203], v[202:203], v[30:31] op_sel_hi:[1,0]
    v_pk_mul_f32 v[204:205], v[204:205], v[30:31] op_sel_hi:[1,0]
    v_pk_mul_f32 v[206:207], v[206:207], v[30:31] op_sel_hi:[1,0]
    v_pk_mul_f32 v[208:209], v[208:209], v[30:31] op_sel_hi:[1,0]
    v_pk_mul_f32 v[210:211], v[210:211], v[30:31] op_sel_hi:[1,0]
    s_waitcnt vmcnt(16)
    ds_read_b64_tr_b16 v[84:85], v18 offset:8192
    ds_read_b64_tr_b16 v[88:89], v19 offset:8192
    ds_read_b64_tr_b16 v[92:93], v20 offset:8192
    ds_read_b64_tr_b16 v[96:97], v21 offset:8192
    ds_read_b64_tr_b16 v[100:101], v22 offset:8192
    ds_read_b64_tr_b16 v[104:105], v23 offset:8192
    ds_read_b64_tr_b16 v[108:109], v24 offset:8192
    ds_read_b64_tr_b16 v[112:113], v25 offset:8192
    ds_read_b64_tr_b16 v[116:117], v18 offset:8448
    ds_read_b64_tr_b16 v[120:121], v19 offset:8448
    ds_read_b64_tr_b16 v[124:125], v20 offset:8448
    ds_read_b64_tr_b16 v[128:129], v21 offset:8448
    ds_read_b64_tr_b16 v[132:133], v22 offset:8448
    ds_read_b64_tr_b16 v[136:137], v23 offset:8448
    ds_read_b64_tr_b16 v[140:141], v24 offset:8448
    ds_read_b64_tr_b16 v[144:145], v25 offset:8448
    s_waitcnt lgkmcnt(0)
    s_add_u32 s39, s38, 32768
    s_add_u32 m0, s37, 0
    s_nop 0
    buffer_load_dwordx4 v10, s[20:23], s39 offen nt lds
    buffer_load_dwordx4 v11, s[20:23], s39 offen offset:1024 nt lds
    buffer_load_dwordx4 v12, s[20:23], s39 offen offset:2048 nt lds
    buffer_load_dwordx4 v13, s[20:23], s39 offen offset:3072 nt lds
    s_add_u32 s39, s38, 36864
    s_add_u32 m0, s37, 4096
    s_nop 0
    buffer_load_dwordx4 v10, s[20:23], s39 offen nt lds
    buffer_load_dwordx4 v11, s[20:23], s39 offen offset:1024 nt lds
    buffer_load_dwordx4 v12, s[20:23], s39 offen offset:2048 nt lds
    buffer_load_dwordx4 v13, s[20:23], s39 offen offset:3072 nt lds
    s_add_u32 s39, s38, 32768
    s_add_u32 m0, s37, 8192
    s_nop 0
    buffer_load_dwordx4 v10, s[24:27], s39 offen nt lds
    buffer_load_dwordx4 v11, s[24:27], s39 offen offset:1024 nt lds
    buffer_load_dwordx4 v12, s[24:27], s39 offen offset:2048 nt lds
    buffer_load_dwordx4 v13, s[24:27], s39 offen offset:3072 nt lds
    s_add_u32 s39, s38, 36864
    s_add_u32 m0, s37, 12288
    s_nop 0
    buffer_load_dwordx4 v10, s[24:27], s39 offen nt lds
    buffer_load_dwordx4 v11, s[24:27], s39 offen offset:1024 nt lds
    buffer_load_dwordx4 v12, s[24:27], s39 offen offset:2048 nt lds
    buffer_load_dwordx4 v13, s[24:27], s39 offen offset:3072 nt lds
    v_mfma_f32_16x16x16_bf16 v[148:151], v[84:85], v[40:41], v[148:151]
    v_mfma_f32_16x16x16_bf16 v[152:155], v[88:89], v[40:41], v[152:155]
    v_mfma_f32_16x16x16_bf16 v[156:159], v[92:93], v[40:41], v[156:159]
    v_mfma_f32_16x16x16_bf16 v[160:163], v[96:97], v[40:41], v[160:163]
    v_mfma_f32_16x16x16_bf16 v[164:167], v[100:101], v[40:41], v[164:167]
    v_mfma_f32_16x16x16_bf16 v[168:171], v[104:105], v[40:41], v[168:171]
    v_mfma_f32_16x16x16_bf16 v[172:175], v[108:109], v[40:41], v[172:175]
    v_mfma_f32_16x16x16_bf16 v[176:179], v[112:113], v[40:41], v[176:179]
    v_mfma_f32_16x16x16_bf16 v[180:183], v[116:117], v[40:41], v[180:183]
    v_mfma_f32_16x16x16_bf16 v[184:187], v[120:121], v[40:41], v[184:187]
    v_mfma_f32_16x16x16_bf16 v[188:191], v[124:125], v[40:41], v[188:191]
    v_mfma_f32_16x16x16_bf16 v[192:195], v[128:129], v[40:41], v[192:195]
    v_mfma_f32_16x16x16_bf16 v[196:199], v[132:133], v[40:41], v[196:199]
    v_mfma_f32_16x16x16_bf16 v[200:203], v[136:137], v[40:41], v[200:203]
    v_mfma_f32_16x16x16_bf16 v[204:207], v[140:141], v[40:41], v[204:207]
    v_mfma_f32_16x16x16_bf16 v[208:211], v[144:145], v[40:41], v[208:211]
    s_waitcnt vmcnt(24)
    ds_read_b128 v[84:87], v14 offset:16384
    ds_read_b128 v[88:91], v15 offset:16384
    ds_read_b128 v[92:95], v16 offset:16384
    ds_read_b128 v[96:99], v17 offset:16384
    ds_read_b128 v[100:103], v14 offset:16640
    ds_read_b128 v[104:107], v15 offset:16640
    ds_read_b128 v[108:111], v16 offset:16640
    ds_read_b128 v[112:115], v17 offset:16640
    s_waitcnt lgkmcnt(0)
    v_mfma_f32_16x16x32_bf16 v[32:35], v[84:87], v[52:55], 0
    v_mfma_f32_16x16x32_bf16 v[32:35], v[88:91], v[56:59], v[32:35]
    v_mfma_f32_16x16x32_bf16 v[32:35], v[92:95], v[60:63], v[32:35]
    v_mfma_f32_16x16x32_bf16 v[32:35], v[96:99], v[64:67], v[32:35]
    v_mfma_f32_16x16x32_bf16 v[32:35], v[100:103], v[68:71], v[32:35]
    v_mfma_f32_16x16x32_bf16 v[32:35], v[104:107], v[72:75], v[32:35]
    v_mfma_f32_16x16x32_bf16 v[32:35], v[108:111], v[76:79], v[32:35]
    v_mfma_f32_16x16x32_bf16 v[32:35], v[112:115], v[80:83], v[32:35]
    s_nop 7
    v_max3_f32 v2, v32, v33, v34
    v_max_f32 v2, v2, v35
    v_mov_b32 v3, v2
    s_nop 1
    v_permlane32_swap_b32 v2, v3
    s_nop 0
    v_max_f32 v2, v2, v3
    v_mov_b32 v3, v2
    s_nop 1
    v_permlane16_swap_b32 v2, v3
    s_nop 0
    v_max3_f32 v2, v2, v3, v26
    v_mul_f32 v31, s41, v2
    v_fma_f32 v30, v26, s41, -v31
    v_mov_b32 v26, v2
    v_fma_f32 v44, v32, s41, -v31
    v_fma_f32 v45, v33, s41, -v31
    v_fma_f32 v46, v34, s41, -v31
    v_fma_f32 v47, v35, s41, -v31
    v_exp_f32 v30, v30
    v_exp_f32 v44, v44
    v_exp_f32 v45, v45
    v_exp_f32 v46, v46
    v_exp_f32 v47, v47
    s_nop 0
    v_mul_f32 v27, v27, v30
    v_cvt_pk_bf16_f32 v40, v44, v45
    v_cvt_pk_bf16_f32 v41, v46, v47
    v_add_f32 v2, v44, v45
    v_add_f32 v3, v46, v47
    v_add_f32 v2, v2, v3
    v_add_f32 v27, v27, v2
    v_pk_mul_f32 v[148:149], v[148:149], v[30:31] op_sel_hi:[1,0]
    v_pk_mul_f32 v[150:151], v[150:151], v[30:31] op_sel_hi:[1,0]
    v_pk_mul_f32 v[152:153], v[152:153], v[30:31] op_sel_hi:[1,0]
    v_pk_mul_f32 v[154:155], v[154:155], v[30:31] op_sel_hi:[1,0]
    v_pk_mul_f32 v[156:157], v[156:157], v[30:31] op_sel_hi:[1,0]
    v_pk_mul_f32 v[158:159], v[158:159], v[30:31] op_sel_hi:[1,0]
    v_pk_mul_f32 v[160:161], v[160:161], v[30:31] op_sel_hi:[1,0]
    v_pk_mul_f32 v[162:163], v[162:163], v[30:31] op_sel_hi:[1,0]
    v_pk_mul_f32 v[164:165], v[164:165], v[30:31] op_sel_hi:[1,0]
    v_pk_mul_f32 v[166:167], v[166:167], v[30:31] op_sel_hi:[1,0]
    v_pk_mul_f32 v[168:169], v[168:169], v[30:31] op_sel_hi:[1,0]
    v_pk_mul_f32 v[170:171], v[170:171], v[30:31] op_sel_hi:[1,0]
    v_pk_mul_f32 v[172:173], v[172:173], v[30:31] op_sel_hi:[1,0]
    v_pk_mul_f32 v[174:175], v[174:175], v[30:31] op_sel_hi:[1,0]
    v_pk_mul_f32 v[176:177], v[176:177], v[30:31] op_sel_hi:[1,0]
    v_pk_mul_f32 v[178:179], v[178:179], v[30:31] op_sel_hi:[1,0]
    v_pk_mul_f32 v[180:181], v[180:181], v[30:31] op_sel_hi:[1,0]
    v_pk_mul_f32 v[182:183], v[182:183], v[30:31] op_sel_hi:[1,0]
    v_pk_mul_f32 v[184:185], v[184:185], v[30:31] op_sel_hi:[1,0]
    v_pk_mul_f32 v[186:187], v[186:187], v[30:31] op_sel_hi:[1,0]
    v_pk_mul_f32 v[188:189], v[188:189], v[30:31] op_sel_hi:[1,0]
    v_pk_mul_f32 v[190:191], v[190:191], v[30:31] op_sel_hi:[1,0]
    v_pk_mul_f32 v[192:193], v[192:193], v[30:31] op_sel_hi:[1,0]
    v_pk_mul_f32 v[194:195], v[194:195], v[30:31] op_sel_hi:[1,0]
    v_pk_mul_f32 v[196:197], v[196:197], v[30:31] op_sel_hi:[1,0]
    v_pk_mul_f32 v[198:199], v[198:199], v[30:31] op_sel_hi:[1,0]
    v_pk_mul_f32 v[200:201], v[200:201], v[30:31] op_sel_hi:[1,0]
    v_pk_mul_f32 v[202:203], v[202:203], v[30:31] op_sel_hi:[1,0]
    v_pk_mul_f32 v[204:205], v[204:205], v[30:31] op_sel_hi:[1,0]
    v_pk_mul_f32 v[206:207], v[206:207], v[30:31] op_sel_hi:[1,0]
    v_pk_mul_f32 v[208:209], v[208:209], v[30:31] op_sel_hi:[1,0]
    v_pk_mul_f32 v[210:211], v[210:211], v[30:31] op_sel_hi:[1,0]
    s_waitcnt vmcnt(16)
    ds_read_b64_tr_b16 v[84:85], v18 offset:24576
    ds_read_b64_tr_b16 v[88:89], v19 offset:24576
    ds_read_b64_tr_b16 v[92:93], v20 offset:24576
    ds_read_b64_tr_b16 v[96:97], v21 offset:24576
    ds_read_b64_tr_b16 v[100:101], v22 offset:24576
    ds_read_b64_tr_b16 v[104:105], v23 offset:24576
    ds_read_b64_tr_b16 v[108:109], v24 offset:24576
    ds_read_b64_tr_b16 v[112:113], v25 offset:24576
    ds_read_b64_tr_b16 v[116:117], v18 offset:24832
    ds_read_b64_tr_b16 v[120:121], v19 offset:24832
    ds_read_b64_tr_b16 v[124:125], v20 offset:24832
    ds_read_b64_tr_b16 v[128:129], v21 offset:24832
    ds_read_b64_tr_b16 v[132:133], v22 offset:24832
    ds_read_b64_tr_b16 v[136:137], v23 offset:24832
    ds_read_b64_tr_b16 v[140:141], v24 offset:24832
    ds_read_b64_tr_b16 v[144:145], v25 offset:24832
    s_waitcnt lgkmcnt(0)
    s_add_u32 s39, s38, 49152
    s_add_u32 m0, s37, 16384
    s_nop 0
    buffer_load_dwordx4 v10, s[20:23], s39 offen nt lds
    buffer_load_dwordx4 v11, s[20:23], s39 offen offset:1024 nt lds
    buffer_load_dwordx4 v12, s[20:23], s39 offen offset:2048 nt lds
    buffer_load_dwordx4 v13, s[20:23], s39 offen offset:3072 nt lds
    s_add_u32 s39, s38, 53248
    s_add_u32 m0, s37, 20480
    s_nop 0
    buffer_load_dwordx4 v10, s[20:23], s39 offen nt lds
    buffer_load_dwordx4 v11, s[20:23], s39 offen offset:1024 nt lds
    buffer_load_dwordx4 v12, s[20:23], s39 offen offset:2048 nt lds
    buffer_load_dwordx4 v13, s[20:23], s39 offen offset:3072 nt lds
    s_add_u32 s39, s38, 49152
    s_add_u32 m0, s37, 24576
    s_nop 0
    buffer_load_dwordx4 v10, s[24:27], s39 offen nt lds
    buffer_load_dwordx4 v11, s[24:27], s39 offen offset:1024 nt lds
    buffer_load_dwordx4 v12, s[24:27], s39 offen offset:2048 nt lds
    buffer_load_dwordx4 v13, s[24:27], s39 offen offset:3072 nt lds
    s_add_u32 s39, s38, 53248
    s_add_u32 m0, s37, 28672
    s_nop 0
    buffer_load_dwordx4 v10, s[24:27], s39 offen nt lds
    buffer_load_dwordx4 v11, s[24:27], s39 offen offset:1024 nt lds
    buffer_load_dwordx4 v12, s[24:27], s39 offen offset:2048 nt lds
    buffer_load_dwordx4 v13, s[24:27], s39 offen offset:3072 nt lds
    v_mfma_f32_16x16x16_bf16 v[148:151], v[84:85], v[40:41], v[148:151]
    v_mfma_f32_16x16x16_bf16 v[152:155], v[88:89], v[40:41], v[152:155]
    v_mfma_f32_16x16x16_bf16 v[156:159], v[92:93], v[40:41], v[156:159]
    v_mfma_f32_16x16x16_bf16 v[160:163], v[96:97], v[40:41], v[160:163]
    v_mfma_f32_16x16x16_bf16 v[164:167], v[100:101], v[40:41], v[164:167]
    v_mfma_f32_16x16x16_bf16 v[168:171], v[104:105], v[40:41], v[168:171]
    v_mfma_f32_16x16x16_bf16 v[172:175], v[108:109], v[40:41], v[172:175]
    v_mfma_f32_16x16x16_bf16 v[176:179], v[112:113], v[40:41], v[176:179]
    v_mfma_f32_16x16x16_bf16 v[180:183], v[116:117], v[40:41], v[180:183]
    v_mfma_f32_16x16x16_bf16 v[184:187], v[120:121], v[40:41], v[184:187]
    v_mfma_f32_16x16x16_bf16 v[188:191], v[124:125], v[40:41], v[188:191]
    v_mfma_f32_16x16x16_bf16 v[192:195], v[128:129], v[40:41], v[192:195]
    v_mfma_f32_16x16x16_bf16 v[196:199], v[132:133], v[40:41], v[196:199]
    v_mfma_f32_16x16x16_bf16 v[200:203], v[136:137], v[40:41], v[200:203]
    v_mfma_f32_16x16x16_bf16 v[204:207], v[140:141], v[40:41], v[204:207]
    v_mfma_f32_16x16x16_bf16 v[208:211], v[144:145], v[40:41], v[208:211]
    s_add_u32 s38, s38, 32768
    s_sub_u32 s40, s40, 1
    s_cmp_lg_u32 s40, 0
    s_cbranch_scc1 L_eloop
    s_waitcnt vmcnt(24)
    ds_read_b128 v[84:87], v14 offset:0
    ds_read_b128 v[88:91], v15 offset:0
    ds_read_b128 v[92:95], v16 offset:0
    ds_read_b128 v[96:99], v17 offset:0
    ds_read_b128 v[100:103], v14 offset:256
    ds_read_b128 v[104:107], v15 offset:256
    ds_read_b128 v[108:111], v16 offset:256
    ds_read_b128 v[112:115], v17 offset:256
    s_waitcnt lgkmcnt(0)
    v_mfma_f32_16x16x32_bf16 v[32:35], v[84:87], v[52:55], 0
    v_mfma_f32_16x16x32_bf16 v[32:35], v[88:91], v[56:59], v[32:35]
    v_mfma_f32_16x16x32_bf16 v[32:35], v[92:95], v[60:63], v[32:35]
    v_mfma_f32_16x16x32_bf16 v[32:35], v[96:99], v[64:67], v[32:35]
    v_mfma_f32_16x16x32_bf16 v[32:35], v[100:103], v[68:71], v[32:35]
    v_mfma_f32_16x16x32_bf16 v[32:35], v[104:107], v[72:75], v[32:35]
    v_mfma_f32_16x16x32_bf16 v[32:35], v[108:111], v[76:79], v[32:35]
    v_mfma_f32_16x16x32_bf16 v[32:35], v[112:115], v[80:83], v[32:35]
    s_nop 7
    v_max3_f32 v2, v32, v33, v34
    v_max_f32 v2, v2, v35
    v_mov_b32 v3, v2
    s_nop 1
    v_permlane32_swap_b32 v2, v3
    s_nop 0
    v_max_f32 v2, v2, v3
    v_mov_b32 v3, v2
    s_nop 1
    v_permlane16_swap_b32 v2, v3
    s_nop 0
    v_max3_f32 v2, v2, v3, v26
    v_mul_f32 v31, s41, v2
    v_fma_f32 v30, v26, s41, -v31
    v_mov_b32 v26, v2
    v_fma_f32 v44, v32, s41, -v31
    v_fma_f32 v45, v33, s41, -v31
    v_fma_f32 v46, v34, s41, -v31
    v_fma_f32 v47, v35, s41, -v31
    v_exp_f32 v30, v30
    v_exp_f32 v44, v44
    v_exp_f32 v45, v45
    v_exp_f32 v46, v46
    v_exp_f32 v47, v47
    s_nop 0
    v_mul_f32 v27, v27, v30
    v_cvt_pk_bf16_f32 v40, v44, v45
    v_cvt_pk_bf16_f32 v41, v46, v47
    v_add_f32 v2, v44, v45
    v_add_f32 v3, v46, v47
    v_add_f32 v2, v2, v3
    v_add_f32 v27, v27, v2
    v_pk_mul_f32 v[148:149], v[148:149], v[30:31] op_sel_hi:[1,0]
    v_pk_mul_f32 v[150:151], v[150:151], v[30:31] op_sel_hi:[1,0]
    v_pk_mul_f32 v[152:153], v[152:153], v[30:31] op_sel_hi:[1,0]
    v_pk_mul_f32 v[154:155], v[154:155], v[30:31] op_sel_hi:[1,0]
    v_pk_mul_f32 v[156:157], v[156:157], v[30:31] op_sel_hi:[1,0]
    v_pk_mul_f32 v[158:159], v[158:159], v[30:31] op_sel_hi:[1,0]
    v_pk_mul_f32 v[160:161], v[160:161], v[30:31] op_sel_hi:[1,0]
    v_pk_mul_f32 v[162:163], v[162:163], v[30:31] op_sel_hi:[1,0]
    v_pk_mul_f32 v[164:165], v[164:165], v[30:31] op_sel_hi:[1,0]
    v_pk_mul_f32 v[166:167], v[166:167], v[30:31] op_sel_hi:[1,0]
    v_pk_mul_f32 v[168:169], v[168:169], v[30:31] op_sel_hi:[1,0]
    v_pk_mul_f32 v[170:171], v[170:171], v[30:31] op_sel_hi:[1,0]
    v_pk_mul_f32 v[172:173], v[172:173], v[30:31] op_sel_hi:[1,0]
    v_pk_mul_f32 v[174:175], v[174:175], v[30:31] op_sel_hi:[1,0]
    v_pk_mul_f32 v[176:177], v[176:177], v[30:31] op_sel_hi:[1,0]
    v_pk_mul_f32 v[178:179], v[178:179], v[30:31] op_sel_hi:[1,0]
    v_pk_mul_f32 v[180:181], v[180:181], v[30:31] op_sel_hi:[1,0]
    v_pk_mul_f32 v[182:183], v[182:183], v[30:31] op_sel_hi:[1,0]
    v_pk_mul_f32 v[184:185], v[184:185], v[30:31] op_sel_hi:[1,0]
    v_pk_mul_f32 v[186:187], v[186:187], v[30:31] op_sel_hi:[1,0]
    v_pk_mul_f32 v[188:189], v[188:189], v[30:31] op_sel_hi:[1,0]
    v_pk_mul_f32 v[190:191], v[190:191], v[30:31] op_sel_hi:[1,0]
    v_pk_mul_f32 v[192:193], v[192:193], v[30:31] op_sel_hi:[1,0]
    v_pk_mul_f32 v[194:195], v[194:195], v[30:31] op_sel_hi:[1,0]
    v_pk_mul_f32 v[196:197], v[196:197], v[30:31] op_sel_hi:[1,0]
    v_pk_mul_f32 v[198:199], v[198:199], v[30:31] op_sel_hi:[1,0]
    v_pk_mul_f32 v[200:201], v[200:201], v[30:31] op_sel_hi:[1,0]
    v_pk_mul_f32 v[202:203], v[202:203], v[30:31] op_sel_hi:[1,0]
    v_pk_mul_f32 v[204:205], v[204:205], v[30:31] op_sel_hi:[1,0]
    v_pk_mul_f32 v[206:207], v[206:207], v[30:31] op_sel_hi:[1,0]
    v_pk_mul_f32 v[208:209], v[208:209], v[30:31] op_sel_hi:[1,0]
    v_pk_mul_f32 v[210:211], v[210:211], v[30:31] op_sel_hi:[1,0]
    s_waitcnt vmcnt(16)
    ds_read_b64_tr_b16 v[84:85], v18 offset:8192
    ds_read_b64_tr_b16 v[88:89], v19 offset:8192
    ds_read_b64_tr_b16 v[92:93], v20 offset:8192
    ds_read_b64_tr_b16 v[96:97], v21 offset:8192
    ds_read_b64_tr_b16 v[100:101], v22 offset:8192
    ds_read_b64_tr_b16 v[104:105], v23 offset:8192
    ds_read_b64_tr_b16 v[108:109], v24 offset:8192
    ds_read_b64_tr_b16 v[112:113], v25 offset:8192
    ds_read_b64_tr_b16 v[116:117], v18 offset:8448
    ds_read_b64_tr_b16 v[120:121], v19 offset:8448
    ds_read_b64_tr_b16 v[124:125], v20 offset:8448
    ds_read_b64_tr_b16 v[128:129], v21 offset:8448
    ds_read_b64_tr_b16 v[132:133], v22 offset:8448
    ds_read_b64_tr_b16 v[136:137], v23 offset:8448
    ds_read_b64_tr_b16 v[140:141], v24 offset:8448
    ds_read_b64_tr_b16 v[144:145], v25 offset:8448
    s_waitcnt lgkmcnt(0)
    v_mfma_f32_16x16x16_bf16 v[148:151], v[84:85], v[40:41], v[148:151]
    v_mfma_f32_16x16x16_bf16 v[152:155], v[88:89], v[40:41], v[152:155]
    v_mfma_f32_16x16x16_bf16 v[156:159], v[92:93], v[40:41], v[156:159]
    v_mfma_f32_16x16x16_bf16 v[160:163], v[96:97], v[40:41], v[160:163]
    v_mfma_f32_16x16x16_bf16 v[164:167], v[100:101], v[40:41], v[164:167]
    v_mfma_f32_16x16x16_bf16 v[168:171], v[104:105], v[40:41], v[168:171]
    v_mfma_f32_16x16x16_bf16 v[172:175], v[108:109], v[40:41], v[172:175]
    v_mfma_f32_16x16x16_bf16 v[176:179], v[112:113], v[40:41], v[176:179]
    v_mfma_f32_16x16x16_bf16 v[180:183], v[116:117], v[40:41], v[180:183]
    v_mfma_f32_16x16x16_bf16 v[184:187], v[120:121], v[40:41], v[184:187]
    v_mfma_f32_16x16x16_bf16 v[188:191], v[124:125], v[40:41], v[188:191]
    v_mfma_f32_16x16x16_bf16 v[192:195], v[128:129], v[40:41], v[192:195]
    v_mfma_f32_16x16x16_bf16 v[196:199], v[132:133], v[40:41], v[196:199]
    v_mfma_f32_16x16x16_bf16 v[200:203], v[136:137], v[40:41], v[200:203]
    v_mfma_f32_16x16x16_bf16 v[204:207], v[140:141], v[40:41], v[204:207]
    v_mfma_f32_16x16x16_bf16 v[208:211], v[144:145], v[40:41], v[208:211]
    s_waitcnt vmcnt(8)
    ds_read_b128 v[84:87], v14 offset:16384
    ds_read_b128 v[88:91], v15 offset:16384
    ds_read_b128 v[92:95], v16 offset:16384
    ds_read_b128 v[96:99], v17 offset:16384
    ds_read_b128 v[100:103], v14 offset:16640
    ds_read_b128 v[104:107], v15 offset:16640
    ds_read_b128 v[108:111], v16 offset:16640
    ds_read_b128 v[112:115], v17 offset:16640
    s_waitcnt lgkmcnt(0)
    v_mfma_f32_16x16x32_bf16 v[32:35], v[84:87], v[52:55], 0
    v_mfma_f32_16x16x32_bf16 v[32:35], v[88:91], v[56:59], v[32:35]
    v_mfma_f32_16x16x32_bf16 v[32:35], v[92:95], v[60:63], v[32:35]
    v_mfma_f32_16x16x32_bf16 v[32:35], v[96:99], v[64:67], v[32:35]
    v_mfma_f32_16x16x32_bf16 v[32:35], v[100:103], v[68:71], v[32:35]
    v_mfma_f32_16x16x32_bf16 v[32:35], v[104:107], v[72:75], v[32:35]
    v_mfma_f32_16x16x32_bf16 v[32:35], v[108:111], v[76:79], v[32:35]
    v_mfma_f32_16x16x32_bf16 v[32:35], v[112:115], v[80:83], v[32:35]
    s_nop 7
    v_max3_f32 v2, v32, v33, v34
    v_max_f32 v2, v2, v35
    v_mov_b32 v3, v2
    s_nop 1
    v_permlane32_swap_b32 v2, v3
    s_nop 0
    v_max_f32 v2, v2, v3
    v_mov_b32 v3, v2
    s_nop 1
    v_permlane16_swap_b32 v2, v3
    s_nop 0
    v_max3_f32 v2, v2, v3, v26
    v_mul_f32 v31, s41, v2
    v_fma_f32 v30, v26, s41, -v31
    v_mov_b32 v26, v2
    v_fma_f32 v44, v32, s41, -v31
    v_fma_f32 v45, v33, s41, -v31
    v_fma_f32 v46, v34, s41, -v31
    v_fma_f32 v47, v35, s41, -v31
    v_exp_f32 v30, v30
    v_exp_f32 v44, v44
    v_exp_f32 v45, v45
    v_exp_f32 v46, v46
    v_exp_f32 v47, v47
    s_nop 0
    v_mul_f32 v27, v27, v30
    v_add_f32 v2, v44, v45
    v_add_f32 v3, v46, v47
    v_add_f32 v2, v2, v3
    v_add_f32 v27, v27, v2
    v_mov_b32 v3, v27
    s_nop 1
    v_permlane32_swap_b32 v27, v3
    s_nop 0
    v_add_f32 v27, v27, v3
    v_mov_b32 v3, v27
    s_nop 1
    v_permlane16_swap_b32 v27, v3
    s_nop 0
    v_add_f32 v27, v27, v3
    ds_write_b64 v221, v[26:27]
    s_waitcnt lgkmcnt(0)
    s_barrier
    ds_read_b64 v[240:241], v222 offset:0
    ds_read_b64 v[242:243], v222 offset:128
    s_waitcnt lgkmcnt(0)
    v_max_f32 v2, v240, v242
    v_mul_f32 v31, s41, v2
    v_fma_f32 v240, v240, s41, -v31
    v_fma_f32 v242, v242, s41, -v31
    v_fma_f32 v3, v26, s41, -v31
    v_exp_f32 v240, v240
    v_exp_f32 v242, v242
    v_exp_f32 v3, v3
    s_nop 0
    v_mul_f32 v2, v240, v241
    v_fma_f32 v2, v242, v243, v2
    v_rcp_f32 v2, v2
    s_nop 0
    v_mul_f32 v2, v2, v3
    v_mul_f32 v30, v30, v2
    v_mul_f32 v44, v44, v2
    v_mul_f32 v45, v45, v2
    v_mul_f32 v46, v46, v2
    v_mul_f32 v47, v47, v2
    v_cvt_pk_bf16_f32 v40, v44, v45
    v_cvt_pk_bf16_f32 v41, v46, v47
    v_pk_mul_f32 v[148:149], v[148:149], v[30:31] op_sel_hi:[1,0]
    v_pk_mul_f32 v[150:151], v[150:151], v[30:31] op_sel_hi:[1,0]
    v_pk_mul_f32 v[152:153], v[152:153], v[30:31] op_sel_hi:[1,0]
    v_pk_mul_f32 v[154:155], v[154:155], v[30:31] op_sel_hi:[1,0]
    v_pk_mul_f32 v[156:157], v[156:157], v[30:31] op_sel_hi:[1,0]
    v_pk_mul_f32 v[158:159], v[158:159], v[30:31] op_sel_hi:[1,0]
    v_pk_mul_f32 v[160:161], v[160:161], v[30:31] op_sel_hi:[1,0]
    v_pk_mul_f32 v[162:163], v[162:163], v[30:31] op_sel_hi:[1,0]
    v_pk_mul_f32 v[164:165], v[164:165], v[30:31] op_sel_hi:[1,0]
    v_pk_mul_f32 v[166:167], v[166:167], v[30:31] op_sel_hi:[1,0]
    v_pk_mul_f32 v[168:169], v[168:169], v[30:31] op_sel_hi:[1,0]
    v_pk_mul_f32 v[170:171], v[170:171], v[30:31] op_sel_hi:[1,0]
    v_pk_mul_f32 v[172:173], v[172:173], v[30:31] op_sel_hi:[1,0]
    v_pk_mul_f32 v[174:175], v[174:175], v[30:31] op_sel_hi:[1,0]
    v_pk_mul_f32 v[176:177], v[176:177], v[30:31] op_sel_hi:[1,0]
    v_pk_mul_f32 v[178:179], v[178:179], v[30:31] op_sel_hi:[1,0]
    v_pk_mul_f32 v[180:181], v[180:181], v[30:31] op_sel_hi:[1,0]
    v_pk_mul_f32 v[182:183], v[182:183], v[30:31] op_sel_hi:[1,0]
    v_pk_mul_f32 v[184:185], v[184:185], v[30:31] op_sel_hi:[1,0]
    v_pk_mul_f32 v[186:187], v[186:187], v[30:31] op_sel_hi:[1,0]
    v_pk_mul_f32 v[188:189], v[188:189], v[30:31] op_sel_hi:[1,0]
    v_pk_mul_f32 v[190:191], v[190:191], v[30:31] op_sel_hi:[1,0]
    v_pk_mul_f32 v[192:193], v[192:193], v[30:31] op_sel_hi:[1,0]
    v_pk_mul_f32 v[194:195], v[194:195], v[30:31] op_sel_hi:[1,0]
    v_pk_mul_f32 v[196:197], v[196:197], v[30:31] op_sel_hi:[1,0]
    v_pk_mul_f32 v[198:199], v[198:199], v[30:31] op_sel_hi:[1,0]
    v_pk_mul_f32 v[200:201], v[200:201], v[30:31] op_sel_hi:[1,0]
    v_pk_mul_f32 v[202:203], v[202:203], v[30:31] op_sel_hi:[1,0]
    v_pk_mul_f32 v[204:205], v[204:205], v[30:31] op_sel_hi:[1,0]
    v_pk_mul_f32 v[206:207], v[206:207], v[30:31] op_sel_hi:[1,0]
    v_pk_mul_f32 v[208:209], v[208:209], v[30:31] op_sel_hi:[1,0]
    v_pk_mul_f32 v[210:211], v[210:211], v[30:31] op_sel_hi:[1,0]
    s_waitcnt vmcnt(0)
    ds_read_b64_tr_b16 v[84:85], v18 offset:24576
    ds_read_b64_tr_b16 v[88:89], v19 offset:24576
    ds_read_b64_tr_b16 v[92:93], v20 offset:24576
    ds_read_b64_tr_b16 v[96:97], v21 offset:24576
    ds_read_b64_tr_b16 v[100:101], v22 offset:24576
    ds_read_b64_tr_b16 v[104:105], v23 offset:24576
    ds_read_b64_tr_b16 v[108:109], v24 offset:24576
    ds_read_b64_tr_b16 v[112:113], v25 offset:24576
    ds_read_b64_tr_b16 v[116:117], v18 offset:24832
    ds_read_b64_tr_b16 v[120:121], v19 offset:24832
    ds_read_b64_tr_b16 v[124:125], v20 offset:24832
    ds_read_b64_tr_b16 v[128:129], v21 offset:24832
    ds_read_b64_tr_b16 v[132:133], v22 offset:24832
    ds_read_b64_tr_b16 v[136:137], v23 offset:24832
    ds_read_b64_tr_b16 v[140:141], v24 offset:24832
    ds_read_b64_tr_b16 v[144:145], v25 offset:24832
    s_waitcnt lgkmcnt(0)
    v_mfma_f32_16x16x16_bf16 v[148:151], v[84:85], v[40:41], v[148:151]
    v_mfma_f32_16x16x16_bf16 v[152:155], v[88:89], v[40:41], v[152:155]
    v_mfma_f32_16x16x16_bf16 v[156:159], v[92:93], v[40:41], v[156:159]
    v_mfma_f32_16x16x16_bf16 v[160:163], v[96:97], v[40:41], v[160:163]
    v_mfma_f32_16x16x16_bf16 v[164:167], v[100:101], v[40:41], v[164:167]
    v_mfma_f32_16x16x16_bf16 v[168:171], v[104:105], v[40:41], v[168:171]
    v_mfma_f32_16x16x16_bf16 v[172:175], v[108:109], v[40:41], v[172:175]
    v_mfma_f32_16x16x16_bf16 v[176:179], v[112:113], v[40:41], v[176:179]
    v_mfma_f32_16x16x16_bf16 v[180:183], v[116:117], v[40:41], v[180:183]
    v_mfma_f32_16x16x16_bf16 v[184:187], v[120:121], v[40:41], v[184:187]
    v_mfma_f32_16x16x16_bf16 v[188:191], v[124:125], v[40:41], v[188:191]
    v_mfma_f32_16x16x16_bf16 v[192:195], v[128:129], v[40:41], v[192:195]
    v_mfma_f32_16x16x16_bf16 v[196:199], v[132:133], v[40:41], v[196:199]
    v_mfma_f32_16x16x16_bf16 v[200:203], v[136:137], v[40:41], v[200:203]
    v_mfma_f32_16x16x16_bf16 v[204:207], v[140:141], v[40:41], v[204:207]
    v_mfma_f32_16x16x16_bf16 v[208:211], v[144:145], v[40:41], v[208:211]
    s_nop 1
    ds_write_b128 v212, v[148:151] offset:0
    ds_write_b128 v213, v[152:155] offset:0
    ds_write_b128 v214, v[156:159] offset:0
    ds_write_b128 v215, v[160:163] offset:0
    ds_write_b128 v212, v[164:167] offset:128
    ds_write_b128 v213, v[168:171] offset:128
    ds_write_b128 v214, v[172:175] offset:128
    ds_write_b128 v215, v[176:179] offset:128
    ds_write_b128 v212, v[180:183] offset:512
    ds_write_b128 v213, v[184:187] offset:512
    ds_write_b128 v214, v[188:191] offset:512
    ds_write_b128 v215, v[192:195] offset:512
    ds_write_b128 v212, v[196:199] offset:640
    ds_write_b128 v213, v[200:203] offset:640
    ds_write_b128 v214, v[204:207] offset:640
    ds_write_b128 v215, v[208:211] offset:640
    s_waitcnt lgkmcnt(0)
    s_barrier
    ds_read_b128 v[84:87], v216 offset:0
    ds_read_b128 v[88:91], v216 offset:256
    ds_read_b128 v[92:95], v216 offset:32768
    ds_read_b128 v[96:99], v216 offset:33024
    ds_read_b128 v[100:103], v216 offset:128
    ds_read_b128 v[104:107], v216 offset:384
    ds_read_b128 v[108:111], v216 offset:32896
    ds_read_b128 v[112:115], v216 offset:33152
    ds_read_b128 v[116:119], v216 offset:512
    ds_read_b128 v[120:123], v216 offset:768
    ds_read_b128 v[124:127], v216 offset:33280
    ds_read_b128 v[128:131], v216 offset:33536
    ds_read_b128 v[132:135], v216 offset:640
    ds_read_b128 v[136:139], v216 offset:896
    ds_read_b128 v[140:143], v216 offset:33408
    ds_read_b128 v[144:147], v216 offset:33664
    s_waitcnt lgkmcnt(12)
    v_pk_add_f32 v[84:85], v[84:85], v[92:93]
    v_pk_add_f32 v[86:87], v[86:87], v[94:95]
    v_pk_add_f32 v[88:89], v[88:89], v[96:97]
    v_pk_add_f32 v[90:91], v[90:91], v[98:99]
    v_cvt_pk_bf16_f32 v32, v84, v85
    v_cvt_pk_bf16_f32 v33, v86, v87
    v_cvt_pk_bf16_f32 v34, v88, v89
    v_cvt_pk_bf16_f32 v35, v90, v91
    buffer_store_dwordx4 v[32:35], v220, s[32:35], 0 offen
    s_waitcnt lgkmcnt(8)
    v_pk_add_f32 v[100:101], v[100:101], v[108:109]
    v_pk_add_f32 v[102:103], v[102:103], v[110:111]
    v_pk_add_f32 v[104:105], v[104:105], v[112:113]
    v_pk_add_f32 v[106:107], v[106:107], v[114:115]
    v_cvt_pk_bf16_f32 v36, v100, v101
    v_cvt_pk_bf16_f32 v37, v102, v103
    v_cvt_pk_bf16_f32 v38, v104, v105
    v_cvt_pk_bf16_f32 v39, v106, v107
    buffer_store_dwordx4 v[36:39], v220, s[32:35], 0 offen offset:128
    s_waitcnt lgkmcnt(4)
    v_pk_add_f32 v[116:117], v[116:117], v[124:125]
    v_pk_add_f32 v[118:119], v[118:119], v[126:127]
    v_pk_add_f32 v[120:121], v[120:121], v[128:129]
    v_pk_add_f32 v[122:123], v[122:123], v[130:131]
    v_cvt_pk_bf16_f32 v44, v116, v117
    v_cvt_pk_bf16_f32 v45, v118, v119
    v_cvt_pk_bf16_f32 v46, v120, v121
    v_cvt_pk_bf16_f32 v47, v122, v123
    buffer_store_dwordx4 v[44:47], v220, s[32:35], 0 offen offset:256
    s_waitcnt lgkmcnt(0)
    v_pk_add_f32 v[132:133], v[132:133], v[140:141]
    v_pk_add_f32 v[134:135], v[134:135], v[142:143]
    v_pk_add_f32 v[136:137], v[136:137], v[144:145]
    v_pk_add_f32 v[138:139], v[138:139], v[146:147]
    v_cvt_pk_bf16_f32 v48, v132, v133
    v_cvt_pk_bf16_f32 v49, v134, v135
    v_cvt_pk_bf16_f32 v50, v136, v137
    v_cvt_pk_bf16_f32 v51, v138, v139
    buffer_store_dwordx4 v[48:51], v220, s[32:35], 0 offen offset:384
L_done:
    s_endpgm
.section .rodata,"a"
.p2align 6
.amdhsa_kernel standalone__tree_speculative_verify_tree_attention_over_candidate_token_tree__sampling_kernel
  .amdhsa_next_free_vgpr 256
  .amdhsa_next_free_sgpr 102
  .amdhsa_accum_offset 256
  .amdhsa_group_segment_fixed_size 0
  .amdhsa_kernarg_size 72
  .amdhsa_user_sgpr_count 2
  .amdhsa_user_sgpr_kernarg_segment_ptr 1
  .amdhsa_system_sgpr_workgroup_id_x 1
.end_amdhsa_kernel
```
